```python
import torch

def _softmax(x, axis=-1):
    return torch.softmax(x, dim=axis)
def _gelu(x):
    return torch.nn.functional.gelu(x, approximate="tanh")
def _silu(x):
    return torch.nn.functional.silu(x)
def _sigmoid(x):
    return torch.sigmoid(x)
def _layernorm(x, axis=-1, eps=1e-5):
    m = x.mean(dim=axis, keepdim=True)
    v = x.var(dim=axis, keepdim=True, unbiased=False)
    return (x - m) / torch.sqrt(v + eps)
def _scatter_add(tgt, idx, src, axis=0):
    return tgt.clone().index_add_(axis, idx, src)
def _segment_sum(src, seg, n):
    out = torch.zeros((n,) + src.shape[1:], dtype=src.dtype)
    return out.index_add_(0, seg, src)
def _pad(x, pw):
    flat = tuple(v for pair in reversed(pw) for v in pair)
    return torch.nn.functional.pad(x, flat)

kernel_name = 'gated_mix__sliding_block_cached__glu_gated_swiglu__decode'

def setup_inputs():

    _w = (lambda a: (lambda t: t.to(torch.bfloat16) if t.is_floating_point() else t)(torch.as_tensor(a)))
    def _A_setup():
        B, Sq, D = 8, 1, 512
        Hq, Hkv, Sk, Dh = 32, 8, 4096, 128
        assert Hq % Hkv == 0, (Hq, Hkv)
        return {
            "x": _w((lambda *s: torch.randn(*s, dtype=torch.bfloat16) * 0.05)(B, Sq, D)),
            "k_cache": _w((lambda *s: torch.randn(*s, dtype=torch.bfloat16) * 3.2)(B, Hkv, Sk, Dh)),
            "v_cache": _w((lambda *s: torch.randn(*s, dtype=torch.bfloat16) * 0.05)(B, Hkv, Sk, Dh)),
            "wq": _w((lambda *s: torch.randn(*s, dtype=torch.bfloat16) * 3.2)(D, Hq * Dh) * (D ** -0.5)),
            "wo": _w((lambda *s: torch.randn(*s, dtype=torch.bfloat16) * 0.05)(Hq * Dh, D) * ((Hq * Dh) ** -0.5)),
        }
    _A_in = _A_setup()

    def _B_setup():
        B, S, D, F = 8, 1, 512, 1792
        return {
            "x": _w((lambda *s: torch.randn(*s, dtype=torch.bfloat16) * 0.05)(B, S, D)),
            "w1": _w((lambda *s: torch.randn(*s, dtype=torch.bfloat16) * 0.2)(D, F) * (2.0 / D) ** 0.5),
            "w3": _w((lambda *s: torch.randn(*s, dtype=torch.bfloat16) * 0.2)(D, F) * (2.0 / D) ** 0.5),
            "w2": _w((lambda *s: torch.randn(*s, dtype=torch.bfloat16) * 0.2)(F, D) * (2.0 / F) ** 0.5),
        }
    _B_in = _B_setup()

    return {
        "A_x": _A_in["x"],
        "A_k_cache": _A_in["k_cache"],
        "A_v_cache": _A_in["v_cache"],
        "A_wq": _A_in["wq"],
        "A_wo": _A_in["wo"],
        "B_x": _B_in["x"],
        "B_w1": _B_in["w1"],
        "B_w3": _B_in["w3"],
        "B_w2": _B_in["w2"],
        "gate_w": _w((lambda *s: torch.randn(*s, dtype=torch.bfloat16) * 0.05)(512) * 16.0),
    }

def reference(A_x, A_k_cache, A_v_cache, A_wq, A_wo, B_x, B_w1, B_w3, B_w2, gate_w):
    def _A_ref(x, k_cache, v_cache, wq, wo):
        B, Sq, D = x.shape
        Hq, Dh = 32, 128
        Hkv, Sk = k_cache.shape[1], k_cache.shape[2]
        W = min(4096, max(256, Sk // 4))
        rep = Hq // Hkv
        q = (lambda x, *d: x.permute(*d))((x @ wq).reshape(B, Sq, Hq, Dh), 0, 2, 1, 3)
        k = (lambda x, n, axis: torch.repeat_interleave(x, n, dim=axis))(k_cache[:, :, Sk - W:, :], rep, axis=1)
        v = (lambda x, n, axis: torch.repeat_interleave(x, n, dim=axis))(v_cache[:, :, Sk - W:, :], rep, axis=1)
        scores = torch.einsum("bhqd,bhkd->bhqk", q, k) * (Dh ** -0.5)
        p = _softmax(scores, axis=-1)
        o = torch.einsum("bhqk,bhkd->bhqd", p, v)
        return (lambda x, *d: x.permute(*d))(o, 0, 2, 1, 3).reshape(B, Sq, Hq * Dh) @ wo

    def _B_ref(x, w1, w3, w2):
        gate = torch.einsum("bsd,df->bsf", x, w1)
        up = torch.einsum("bsd,df->bsf", x, w3)
        h = _silu(gate) * up
        out = torch.einsum("bsf,fd->bsd", h, w2)
        return out

    x = A_x
    g = _sigmoid((x * gate_w).sum(-1, keepdims=True))
    a = _A_ref(x, A_k_cache, A_v_cache, A_wq, A_wo)
    b = _B_ref(x, B_w1, B_w3, B_w2)
    return g * a + (1 - g) * b
```

```asm
; @launch grid=(256,1,1) block=(320,1,1) lds=163840
.amdgcn_target "amdgcn-amd-amdhsa--gfx950"
.text
.globl gated_mix__sliding_block_cached__glu_gated_swiglu__decode_kernel
.p2align 8
.type gated_mix__sliding_block_cached__glu_gated_swiglu__decode_kernel,@function
gated_mix__sliding_block_cached__glu_gated_swiglu__decode_kernel:
    s_load_dwordx16 s[4:19], s[0:1], 0
    s_load_dwordx4 s[24:27], s[0:1], 88
    s_cmpk_ge_u32 s2, 256
    s_cbranch_scc1 L_end
    v_cmp_gt_u32 vcc, 64, v0
    s_and_b32 s30, s2, 7
    s_lshr_b32 s31, s2, 3
    s_cbranch_vccz L_tiledone
    s_mul_i32 s53, s30, 7
    s_add_i32 s33, s53, -7
    s_ashr_i32 s33, s33, 1
    s_lshr_b32 s34, s31, 2
    s_add_i32 s33, s33, s34
    s_lshr_b32 s34, s31, 1
    s_lshl3_add_u32 s34, s30, s34
    s_movk_i32 s32, 0x2000
    s_cmp_lt_u32 s31, 16
    s_cselect_b32 s33, s34, s33
    s_cselect_b32 s32, s32, 3584
    v_lshrrev_b32 v16, 3, v0
    v_and_b32 v13, 7, v0
    v_and_b32 v15, 2, v16
    v_xor_b32 v13, v13, v15
    v_mul_u32_u24 v8, s32, v16
    v_lshl_add_u32 v8, v13, 4, v8
    s_and_b32 s34, s2, 8
    s_mul_i32 s34, s34, s32
    s_lshl2_add_u32 s33, s33, s34
    s_lshl_b32 s33, s33, 5
    s_lshl_b32 s36, s32, 3
    v_xor_b32 v9, 64, v8
    s_getreg_b32 s56, hwreg(HW_REG_XCC_ID, 0, 4)
    s_bitset1_b32 s56, 7
    v_mov_b32 v4, s2
    v_mov_b32 v5, s56
    s_bfm_b32 m0, 2, 15
    s_bfm_b32 s46, 1, 22
    s_mov_b32 s47, 0x20000
    s_and_b32 s54, s2, 0xe1
    s_cmpk_eq_u32 s54, 0xe1
    s_waitcnt lgkmcnt(0)
    global_store_byte v4, v5, s[24:25]
    s_cbranch_scc1 L_notile
    s_bitcmp1_b32 s31, 1
    s_cselect_b64 s[44:45], s[18:19], s[16:17]
    s_cmp_lt_u32 s31, 16
    s_cselect_b64 s[44:45], s[10:11], s[44:45]
L_tile:
    buffer_load_dwordx4 v8, s[44:47], s33 offen nt lds
    s_addk_i32 m0, 0x400
    s_add_u32 s33, s33, s36
    buffer_load_dwordx4 v9, s[44:47], s33 offen nt lds
    s_addk_i32 m0, 0x400
    s_add_u32 s33, s33, s36
    s_bitcmp0_b32 m0, 17
    s_cbranch_scc1 L_tile
L_tiledone:
    s_cbranch_vccz L_compute
    v_lshrrev_b32 v10, 5, v0
    v_and_b32 v11, 31, v0
    v_lshlrev_b32 v14, 1, v10
    v_xor_b32 v11, v11, v14
    v_lshlrev_b32 v11, 4, v11
    v_lshl_add_u32 v10, v10, 10, v11
    s_mov_b32 s40, s4
    s_mov_b32 s41, s5
    s_movk_i32 s42, 0x2000
    s_mov_b32 s43, 0x20000
    s_lshl_b32 s33, s2, 6
    s_and_b32 s33, s33, 512
    s_mov_b32 m0, 131072
    s_nop 0
    buffer_load_dwordx4 v10, s[40:43], s33 offen offset:0 lds
    v_xor_b32 v11, 64, v10
    s_addk_i32 s33, 0x400
    buffer_load_dwordx4 v11, s[40:43], s33 offen offset:1024 lds
    v_xor_b32 v11, 128, v10
    s_addk_i32 s33, 0x400
    buffer_load_dwordx4 v11, s[40:43], s33 offen offset:2048 lds
    v_xor_b32 v11, 192, v10
    s_addk_i32 s33, 0x400
    buffer_load_dwordx4 v11, s[40:43], s33 offen offset:3072 lds
    s_setprio 3
    s_load_dwordx2 s[20:21], s[0:1], 64
    s_mov_b32 s3, 0
    v_lshlrev_b32 v2, 4, v0
    v_mov_b32 v4, 0
    v_mov_b32 v5, 0
    v_mov_b32 v6, 0
    v_mov_b32 v7, 0
    v_add_u32 v3, 155648, v2
    ds_write_b128 v3, v[4:7]
    ds_write_b128 v3, v[4:7] offset:1024
    v_lshrrev_b32 v12, 4, v0
    v_lshlrev_b32 v17, 4, v13
    v_lshlrev_b32 v18, 2, v0
    v_add_u32 v18, 155648, v18
    v_mov_b32 v19, -4
    s_add_u32 s53, s53, 1
    s_lshr_b32 s53, s53, 1
    s_mov_b32 s40, s6
    s_mov_b32 s41, s7
    s_mov_b32 s42, 67108864
    s_mov_b32 s43, 0x20000
    s_lshr_b32 s59, s31, 2
    s_lshl3_add_u32 s59, s59, s30
    s_and_b32 s48, s31, 3
    s_lshl4_add_u32 s59, s59, s48
    s_add_u32 s59, s59, 12
    s_lshl_b32 s59, s59, 16
    s_and_b32 s32, s31, 15
    s_lshl_b32 s32, s32, 12
    s_add_u32 s32, s32, s59
    s_mov_b32 s33, s32
    v_and_b32 v13, 15, v0
    v_lshlrev_b32 v14, 8, v12
    v_add_u32 v15, 0, v12
    v_xor_b32 v15, v15, v13
    v_lshl_add_u32 v8, v15, 4, v14
    v_add_u32 v15, 4, v12
    v_xor_b32 v15, v15, v13
    v_lshl_add_u32 v9, v15, 4, v14
    v_add_u32 v15, 8, v12
    v_xor_b32 v15, v15, v13
    v_lshl_add_u32 v10, v15, 4, v14
    v_add_u32 v15, 12, v12
    v_xor_b32 v15, v15, v13
    v_lshl_add_u32 v11, v15, 4, v14
    s_waitcnt lgkmcnt(0)
    s_barrier
    s_mov_b32 s37, 0
L_ld_1:
    s_waitcnt vmcnt(40)
    ds_write_b32 v18, v19 offset:0
    s_mov_b32 m0, s37
    s_add_u32 s37, s37, 4096
    buffer_load_dwordx4 v8, s[40:43], s33 offen offset:0 nt lds
    buffer_load_dwordx4 v9, s[40:43], s33 offen offset:1024 nt lds
    buffer_load_dwordx4 v10, s[40:43], s33 offen offset:2048 nt lds
    buffer_load_dwordx4 v11, s[40:43], s33 offen offset:3072 nt lds
    v_add_u32 v19, 4, v19
    s_add_u32 s33, s33, 4096
    s_and_b32 s33, s33, 0xffff
    s_or_b32 s33, s33, s59
    s_cmp_lt_u32 s37, 24576
    s_cbranch_scc1 L_ld_1
    v_add_u32 v19, 16, v19
    s_mov_b32 s37, 24576
L_ld_2:
    s_waitcnt vmcnt(24)
    ds_write_b32 v18, v19 offset:0
    s_mov_b32 m0, s37
    s_add_u32 s37, s37, 4096
    buffer_load_dwordx4 v8, s[40:43], s33 offen offset:0 nt lds
    buffer_load_dwordx4 v9, s[40:43], s33 offen offset:1024 nt lds
    buffer_load_dwordx4 v10, s[40:43], s33 offen offset:2048 nt lds
    buffer_load_dwordx4 v11, s[40:43], s33 offen offset:3072 nt lds
    v_add_u32 v19, 4, v19
    s_add_u32 s33, s33, 4096
    s_and_b32 s33, s33, 0xffff
    s_or_b32 s33, s33, s59
    s_cmp_lt_u32 s37, 65536
    s_cbranch_scc1 L_ld_2
    s_branch L_loader3
L_compute:
    s_waitcnt lgkmcnt(0)
    s_load_dwordx2 s[48:49], s[26:27], 0
    s_load_dwordx2 s[28:29], s[0:1], 80
    s_getpc_b64 s[38:39]
    v_lshlrev_b32 v1, 5, v0
    global_load_dword v63, v1, s[38:39] offset:-2048
    v_lshrrev_b32 v1, 6, v0
    v_and_b32 v0, 63, v0
    v_readfirstlane_b32 s3, v1
    v_lshlrev_b32 v2, 4, v0
    s_sub_u32 s3, s3, 1
    s_mov_b32 s50, 0
    s_getreg_b32 s56, hwreg(HW_REG_XCC_ID, 0, 4)
    s_lshr_b32 s32, s31, 2
    s_and_b32 s33, s31, 3
    s_lshl_b32 s35, s30, 2
    s_add_u32 s35, s35, s33
    s_and_b32 s34, s31, 1
    v_lshlrev_b32 v3, 2, v0
    v_add_u32 v3, 155648, v3
    v_mov_b32 v9, 1
    v_and_b32 v4, 15, v0
    v_lshrrev_b32 v5, 4, v0
    v_and_b32 v6, 3, v0
    v_bfe_u32 v7, v0, 2, 2
    v_and_b32 v8, 7, v0
    v_lshlrev_b32 v194, 10, v8
    v_lshl_add_u32 v194, v5, 3, v194
    s_or_b32 s56, s56, 0x80
    v_and_b32 v29, 31, v0
    v_lshl_add_u32 v29, v29, 3, s30
    v_lshlrev_b32 v17, 1, v8
    v_lshlrev_b32 v16, 9, v8
    v_add_u32 v16, 131072, v16
    v_add_u32 v18, 0, v5
    v_xor_b32 v18, v18, v17
    v_lshl_add_u32 v204, v18, 4, v16
    v_add_u32 v18, 4, v5
    v_xor_b32 v18, v18, v17
    v_lshl_add_u32 v205, v18, 4, v16
    v_add_u32 v18, 8, v5
    v_xor_b32 v18, v18, v17
    v_lshl_add_u32 v206, v18, 4, v16
    v_add_u32 v18, 12, v5
    v_xor_b32 v18, v18, v17
    v_lshl_add_u32 v207, v18, 4, v16
    global_load_ubyte v180, v29, s[24:25] sc1
    s_barrier
    s_mov_b32 s40, s26
    s_mov_b32 s41, s27
    s_mov_b32 s42, 2097152
    s_mov_b32 s43, 0x20000
    s_lshl_b32 s47, s3, 1
    v_lshl_add_u32 v16, v5, 3, v7
    v_lshlrev_b32 v16, 7, v16
    v_lshrrev_b32 v17, 1, v7
    v_and_b32 v18, 1, v5
    v_lshl_add_u32 v17, v18, 1, v17
    v_lshlrev_b32 v17, 1, v17
    v_lshrrev_b32 v18, 1, v6
    v_add_u32 v18, s47, v18
    v_xor_b32 v17, v17, v18
    v_lshl_add_u32 v16, v17, 4, v16
    v_and_b32 v18, 1, v6
    v_lshl_add_u32 v16, v18, 3, v16
    v_add_u32 v11, 98304, v16
    v_add_u32 v12, 131072, v16
    s_lshr_b32 s16, s30, 1
    s_mul_i32 s16, s16, 7
    s_and_b32 s37, s30, 1
    s_lshl_b32 s37, s37, 2
    s_add_u32 s16, s16, s37
    s_lshr_b32 s36, s31, 2
    s_add_u32 s36, s36, s16
    s_add_u32 s36, s36, 60
    s_add_u32 s37, s36, 28
    s_bitcmp1_b32 s31, 1
    s_cselect_b32 s37, s37, s36
    s_lshl_b32 s36, s30, 3
    s_lshr_b32 s69, s31, 1
    s_add_u32 s36, s36, s69
    s_cmp_lt_u32 s31, 16
    s_cselect_b32 s36, s36, s37
    s_and_b32 s17, s30, 1
    s_lshl_b32 s17, s17, 2
    s_add_u32 s17, s17, s31
    s_lshl_b32 s36, s36, 8
    s_lshl_b32 s37, s3, 6
    s_add_u32 s36, s36, s37
    s_mul_i32 s37, s34, 245760
    s_add_u32 s36, s36, s37
    s_add_u32 s36, s36, 16384
    v_mul_u32_u24 v13, 30720, v8
    v_lshl_add_u32 v13, v5, 4, v13
    v_lshlrev_b32 v14, 14, v6
    v_lshl_add_u32 v14, v7, 6, v14
    v_lshl_add_u32 v14, v5, 4, v14
    v_lshlrev_b32 v15, 9, v6
    s_lshl_b32 s57, s30, 16
    s_lshl_b32 s37, s31, 9
    s_add_u32 s57, s57, s37
    s_lshl_b32 s37, s3, 7
    s_add_u32 s57, s57, s37
    s_add_u32 s57, s57, 524288
    s_lshl_b32 s58, s30, 11
    s_lshl_b32 s44, s31, 4
    s_add_u32 s58, s58, s44
    s_add_u32 s58, s58, 1048576
    s_lshl_b32 s60, s32, 2
    s_add_u32 s60, s60, s3
    s_lshl_b32 s64, s60, 4
    s_add_u32 s64, s64, 12288
    s_lshl_b32 s60, s60, 10
    s_add_u32 s60, s60, 1114112
    v_mov_b32 v1, 0
    v_mov_b32 v16, 0
    v_mov_b32 v17, 0
    v_mov_b32 v18, 0
    v_mov_b32 v19, 0
    v_mov_b32 v21, 0
    s_and_b32 s61, s30, 6
    s_add_u32 s61, s61, s34
    s_lshl_b32 s61, s61, 2
    s_add_u32 s61, s61, s3
    s_lshl_b32 s19, s61, 10
    s_add_u32 s19, s19, 1114112
    s_lshl_b32 s61, s61, 4
    s_add_u32 s61, s61, 12288
    s_cmp_ge_u32 s17, 34
    s_cbranch_scc0 L_nozero
    buffer_store_dwordx4 v[16:19], v2, s[40:43], s19 offen sc1
L_nozero:
    s_waitcnt lgkmcnt(0)
    s_add_u32 s48, s48, 0x7f4a7c15
    s_addc_u32 s49, s49, 0x9e3779b9
    v_mov_b32 v22, s48
    v_mov_b32 v23, s49
    v_lshrrev_b32 v16, 5, v0
    v_and_b32 v17, 31, v0
    v_mul_u32_u24 v18, 245760, v16
    v_lshl_add_u32 v26, v17, 4, v18
    s_mul_i32 s65, s32, 30720
    s_lshl_b32 s37, s30, 11
    s_add_u32 s65, s65, s37
    s_lshl_b32 s37, s3, 9
    s_add_u32 s65, s65, s37
    s_add_u32 s65, s65, 16384
    v_and_b32 v19, 1, v5
    v_mul_u32_u24 v27, 30720, v19
    v_add_u32 v27, v27, v18
    s_bitcmp1_b32 s30, 0
    s_cselect_b32 s18, 12, 16
    s_sub_u32 s19, s18, 1
    v_min_u32 v18, s19, v4
    v_lshl_add_u32 v27, v18, 4, v27
    s_mul_i32 s37, s3, 61440
    s_mul_i32 s44, s33, s18
    s_lshl_b32 s19, s16, 4
    s_add_u32 s44, s44, s19
    s_lshl_b32 s44, s44, 4
    s_add_u32 s37, s37, s44
    s_add_u32 s37, s37, 32768
    s_add_u32 s44, s37, 7168
    v_lshlrev_b32 v28, 4, v4
    s_lshr_b32 s46, s30, 1
    s_lshl_b32 s46, s46, 8
    s_add_u32 s46, s46, 4096
    s_mul_i32 s47, s3, 288
    s_add_u32 s47, s47, 159744
    v_mul_u32_u24 v30, 144, v19
    v_lshl_add_u32 v30, v4, 3, v30
    v_add_u32 v30, s47, v30
    s_mul_i32 s47, s3, 272
    s_add_u32 s47, s47, 160896
    v_lshlrev_b32 v31, 3, v17
    v_add_u32 v31, s47, v31
    v_mul_u32_u24 v52, 272, v6
    v_lshl_add_u32 v52, v5, 4, v52
    v_add_u32 v52, 160896, v52
    v_lshlrev_b32 v188, 11, v16
    v_lshl_add_u32 v188, v17, 4, v188
    v_lshlrev_b32 v189, 6, v16
    v_lshl_add_u32 v189, v6, 4, v189
    s_lshl_b32 s66, s35, 3
    s_lshl_b32 s47, s3, 1
    s_add_u32 s66, s66, s47
    s_lshl_b32 s59, s66, 11
    s_add_u32 s59, s59, 524288
    s_lshl_b32 s66, s66, 6
    s_add_u32 s66, s66, 1048576
    v_add_u32 v16, s47, v16
    v_mul_u32_u24 v190, 272, v16
    v_lshl_add_u32 v190, v17, 3, v190
    v_add_u32 v190, 160896, v190
    v_mul_u32_u24 v191, 272, v8
    v_lshl_add_u32 v191, v5, 4, v191
    v_add_u32 v191, 160896, v191
    v_mul_u32_u24 v192, 144, v8
    v_lshl_add_u32 v192, v5, 4, v192
    v_add_u32 v192, 159744, v192
    v_lshlrev_b32 v193, 2, v0
    v_lshrrev_b32 v16, 3, v4
    v_lshl_add_u32 v194, v16, 2, v194
    v_lshlrev_b32 v208, 3, v5
    v_lshl_add_u32 v208, v16, 2, v208
    v_and_b32 v16, 1, v0
    v_lshl_add_u32 v208, v16, 1, v208
    v_add_u32 v208, 7168, v208
    s_mov_b32 s8, 0x80808080
    s_mov_b32 s9, s8
    s_mov_b32 s10, 0xaaaaaaaa
    s_mov_b32 s11, s10
    s_mov_b32 s12, 0xcccccccc
    s_mov_b32 s13, s12
    s_lshl_b32 s67, s32, 7
    s_lshl_b32 s47, s3, 5
    s_add_u32 s67, s67, s47
    s_lshl_b32 s47, s3, 14
    v_lshlrev_b32 v18, 8, v4
    v_add_u32 v18, s47, v18
    v_add_u32 v19, 0, v5
    v_xor_b32 v19, v19, v4
    v_lshl_add_u32 v53, v19, 4, v18
    v_add_u32 v19, 4, v5
    v_xor_b32 v19, v19, v4
    v_lshl_add_u32 v54, v19, 4, v18
    v_add_u32 v19, 8, v5
    v_xor_b32 v19, v19, v4
    v_lshl_add_u32 v55, v19, 4, v18
    v_add_u32 v19, 12, v5
    v_xor_b32 v19, v19, v4
    v_lshl_add_u32 v56, v19, 4, v18
    s_lshl_b32 s68, s3, 4
    s_add_u32 s68, s68, 52
    v_lshlrev_b32 v57, 4, v6
    v_add_u32 v57, 155648, v57
    v_lshl_add_u32 v59, v5, 6, v57
    s_lshl_b32 s47, s3, 2
    v_add_u32 v58, s47, v57
    s_lshl_b32 s69, s3, 9
    v_add_u32 v60, s69, v59
    v_and_b32 v16, 1, v5
    v_lshl_add_u32 v16, v16, 2, v7
    v_lshlrev_b32 v16, 1, v16
    v_lshrrev_b32 v17, 1, v6
    v_add_u32 v17, s47, v17
    v_lshl_add_u32 v18, v5, 2, v7
    v_lshlrev_b32 v18, 8, v18
    v_and_b32 v19, 1, v6
    v_lshl_add_u32 v18, v19, 3, v18
    v_add_u32 v18, 65536, v18
    v_xor_b32 v19, v17, v16
    v_lshl_add_u32 v24, v19, 4, v18
    v_add_u32 v17, 2, v17
    v_xor_b32 v19, v17, v16
    v_lshl_add_u32 v25, v19, 4, v18
    v_cmp_gt_u32 s[62:63], 8, v4
    v_cmp_eq_u32 s[4:5], 0, v7
    v_cmp_gt_u32 s[6:7], s18, v4
    s_mov_b64 exec, 0xff
    buffer_load_dword v199, v13, s[40:43], s36 offen nt
    s_mov_b64 exec, -1
    s_cmp_ge_i32 s50, 36
    s_cbranch_scc1 L_wd_6
L_wp_5:
    ds_read_b32 v10, v3 offset:0
    s_waitcnt lgkmcnt(0)
    v_readfirstlane_b32 s50, v10
    s_nop 0
    s_cmp_ge_i32 s50, 36
    s_cbranch_scc0 L_wp_5
L_wd_6:
    s_cmp_ge_u32 s17, 32
    s_cbranch_scc1 L_logit
    ds_read_b128 v[64:67], v204 offset:0
    ds_read_b64_tr_b16 v[96:97], v11 offset:0
    ds_read_b64_tr_b16 v[98:99], v11 offset:512
    ds_read_b128 v[68:71], v205 offset:0
    ds_read_b64_tr_b16 v[100:101], v11 offset:4096
    ds_read_b64_tr_b16 v[102:103], v11 offset:4608
    ds_read_b128 v[72:75], v206 offset:0
    ds_read_b64_tr_b16 v[104:105], v11 offset:8192
    ds_read_b64_tr_b16 v[106:107], v11 offset:8704
    ds_read_b128 v[76:79], v207 offset:0
    ds_read_b64_tr_b16 v[108:109], v11 offset:12288
    ds_read_b64_tr_b16 v[110:111], v11 offset:12800
    s_waitcnt lgkmcnt(9)
    v_mfma_f32_16x16x32_bf16 v[16:19], v[96:99], v[64:67], 0
    ds_read_b128 v[80:83], v204 offset:256
    ds_read_b64_tr_b16 v[112:113], v11 offset:16384
    ds_read_b64_tr_b16 v[114:115], v11 offset:16896
    s_waitcnt lgkmcnt(9)
    v_mfma_f32_16x16x32_bf16 v[16:19], v[100:103], v[68:71], v[16:19]
    ds_read_b128 v[84:87], v205 offset:256
    ds_read_b64_tr_b16 v[116:117], v11 offset:20480
    ds_read_b64_tr_b16 v[118:119], v11 offset:20992
    s_waitcnt lgkmcnt(9)
    v_mfma_f32_16x16x32_bf16 v[16:19], v[104:107], v[72:75], v[16:19]
    ds_read_b128 v[88:91], v206 offset:256
    ds_read_b64_tr_b16 v[120:121], v11 offset:24576
    ds_read_b64_tr_b16 v[122:123], v11 offset:25088
    s_waitcnt lgkmcnt(9)
    v_mfma_f32_16x16x32_bf16 v[16:19], v[108:111], v[76:79], v[16:19]
    ds_read_b128 v[92:95], v207 offset:256
    ds_read_b64_tr_b16 v[124:125], v11 offset:28672
    ds_read_b64_tr_b16 v[126:127], v11 offset:29184
    s_waitcnt lgkmcnt(9)
    v_mfma_f32_16x16x32_bf16 v[16:19], v[112:115], v[80:83], v[16:19]
    s_waitcnt lgkmcnt(6)
    v_mfma_f32_16x16x32_bf16 v[16:19], v[116:119], v[84:87], v[16:19]
    s_waitcnt lgkmcnt(3)
    v_mfma_f32_16x16x32_bf16 v[16:19], v[120:123], v[88:91], v[16:19]
    s_waitcnt lgkmcnt(0)
    v_mfma_f32_16x16x32_bf16 v[16:19], v[124:127], v[92:95], v[16:19]
    s_waitcnt vmcnt(1)
    v_cmp_ne_u32 vcc, s56, v180
    s_nop 0
    s_or_b32 s53, vcc_lo, vcc_hi
    ds_add_u32 v3, v9 offset:256
    s_mov_b32 exec_lo, 0x00ff00ff
    s_mov_b32 exec_hi, 0x00ff00ff
    s_nop 0
    v_cvt_pk_bf16_f32 v20, v16, v17
    v_cvt_pk_bf16_f32 v21, v18, v19
    s_cmp_eq_u32 s53, 0
    s_cbranch_scc0 L_ls_7
    buffer_store_dwordx4 v[20:23], v13, s[40:43], s36 offen
L_le_8:
    s_branch L_s1done
L_logit:
    v_lshlrev_b32 v11, 4, v5
    v_add_u32 v11, 98304, v11
    v_xor_b32 v13, 32, v11
    ds_read_b128 v[64:67], v204 offset:0
    ds_read_b128 v[96:99], v11 offset:0
    ds_read_b128 v[68:71], v205 offset:0
    ds_read_b128 v[100:103], v11 offset:64
    ds_read_b128 v[72:75], v206 offset:0
    ds_read_b128 v[104:107], v11 offset:128
    ds_read_b128 v[76:79], v207 offset:0
    ds_read_b128 v[108:111], v11 offset:192
    ds_read_b128 v[80:83], v204 offset:256
    ds_read_b128 v[112:115], v13 offset:256
    ds_read_b128 v[84:87], v205 offset:256
    ds_read_b128 v[116:119], v13 offset:320
    ds_read_b128 v[88:91], v206 offset:256
    ds_read_b128 v[120:123], v13 offset:384
    ds_read_b128 v[92:95], v207 offset:256
    ds_read_b128 v[124:127], v13 offset:448
    s_waitcnt vmcnt(0)
    s_waitcnt lgkmcnt(0)
    ds_add_u32 v3, v9 offset:256
    v_mfma_f32_16x16x32_bf16 v[16:19], v[96:99], v[64:67], 0
    v_mfma_f32_16x16x32_bf16 v[16:19], v[100:103], v[68:71], v[16:19]
    v_mfma_f32_16x16x32_bf16 v[16:19], v[104:107], v[72:75], v[16:19]
    v_mfma_f32_16x16x32_bf16 v[16:19], v[108:111], v[76:79], v[16:19]
    v_mfma_f32_16x16x32_bf16 v[16:19], v[112:115], v[80:83], v[16:19]
    v_mfma_f32_16x16x32_bf16 v[16:19], v[116:119], v[84:87], v[16:19]
    v_mfma_f32_16x16x32_bf16 v[16:19], v[120:123], v[88:91], v[16:19]
    v_mfma_f32_16x16x32_bf16 v[16:19], v[124:127], v[92:95], v[16:19]
    s_lshl_b32 s36, s34, 7
    s_add_u32 s36, s36, s46
    s_cmp_lg_u32 s3, 0
    s_cbranch_scc1 L_s1done
    s_cmp_ge_u32 s17, 34
    s_cbranch_scc1 L_s1done
    s_mov_b64 exec, 0xff
    s_nop 0
    v_mov_b32 v20, v16
    buffer_store_dwordx4 v[20:23], v2, s[40:43], s36 offen sc1
L_s1done:
    s_cmp_ge_u32 s17, 34
    s_cbranch_scc0 L_nozf
    s_mov_b64 exec, 1
    buffer_store_dwordx4 v[20:23], v2, s[40:43], s61 offen sc1
L_nozf:
    s_mov_b64 exec, -1
    s_cmp_ge_i32 s50, 68
    s_cbranch_scc1 L_wd_10
L_wp_9:
    ds_read_b32 v10, v3 offset:0
    s_waitcnt lgkmcnt(0)
    v_readfirstlane_b32 s50, v10
    s_nop 0
    s_cmp_ge_i32 s50, 68
    s_cbranch_scc0 L_wp_9
L_wd_10:
    buffer_load_dwordx4 v[36:39], v26, s[40:43], s65 offen offset:0 sc1
    global_load_ubyte v180, v29, s[24:25] sc1
    s_cmp_ge_i32 s50, 84
    s_cbranch_scc1 L_wd_12
L_wp_11:
    ds_read_b32 v10, v3 offset:0
    s_waitcnt lgkmcnt(0)
    v_readfirstlane_b32 s50, v10
    s_nop 0
    s_cmp_ge_i32 s50, 84
    s_cbranch_scc0 L_wp_11
L_wd_12:
    buffer_load_dwordx4 v[40:43], v26, s[40:43], s65 offen offset:0 sc1
    buffer_load_dwordx4 v[168:171], v27, s[40:43], s37 offen offset:0 sc1
    buffer_load_dwordx4 v[172:175], v27, s[40:43], s44 offen offset:0 sc1
    s_waitcnt vmcnt(3)
    v_cmp_ne_u64 s[54:55], s[48:49], v[38:39]
    s_nop 0
    s_cmp_eq_u64 s[54:55], 0
    s_cbranch_scc1 L_qgot
    s_mov_b32 s52, 0
    s_waitcnt vmcnt(2)
    s_branch L_pc_14
L_pl_13:
    buffer_load_dwordx4 v[40:43], v26, s[40:43], s65 offen offset:0 sc1
    s_waitcnt vmcnt(0)
L_pc_14:
    v_cmp_ne_u64 s[54:55], s[48:49], v[42:43]
    s_nop 0
    s_cmp_eq_u64 s[54:55], 0
    s_cbranch_scc1 L_pd_15
    s_add_u32 s52, s52, 1
    s_cmp_lt_u32 s52, 400000
    s_cbranch_scc1 L_pl_13
L_pd_15:
    v_mov_b32 v36, v40
    v_mov_b32 v37, v41
L_qgot:
    v_and_b32 v19, 0xffff0000, v37
    v_lshlrev_b32 v18, 16, v37
    v_and_b32 v17, 0xffff0000, v36
    v_lshlrev_b32 v16, 16, v36
    v_mov_b32 v44, v16
    v_mov_b32 v45, v17
    v_mov_b32 v46, v18
    v_mov_b32 v47, v19
    v_permlane32_swap_b32 v16, v44
    v_permlane32_swap_b32 v17, v45
    v_permlane32_swap_b32 v18, v46
    v_permlane32_swap_b32 v19, v47
    v_add_f32 v16, v16, v44
    v_add_f32 v17, v17, v45
    v_add_f32 v18, v18, v46
    v_add_f32 v19, v19, v47
    v_cvt_pk_bf16_f32 v16, v16, v17
    v_cvt_pk_bf16_f32 v17, v18, v19
    s_mov_b32 exec_hi, 0
    ds_write_b64 v31, v[16:17]
    s_mov_b32 exec_hi, -1
    s_waitcnt lgkmcnt(0)
    ds_add_u32 v3, v9 offset:512
    s_waitcnt vmcnt(3)
    v_cmp_ne_u32 vcc, s56, v180
    s_nop 0
    s_or_b32 s53, vcc_lo, vcc_hi
    s_cmp_ge_i32 s50, s68
    s_cbranch_scc1 L_wd_17
L_wp_16:
    ds_read_b32 v10, v3 offset:0
    s_waitcnt lgkmcnt(0)
    v_readfirstlane_b32 s50, v10
    s_nop 0
    s_cmp_ge_i32 s50, s68
    s_cbranch_scc0 L_wp_16
L_wd_17:
    ds_read_b128 v[64:67], v53 offset:0
    ds_read_b128 v[68:71], v54 offset:0
    ds_read_b128 v[72:75], v55 offset:0
    ds_read_b128 v[76:79], v56 offset:0
    ds_read_b128 v[80:83], v53 offset:4096
    ds_read_b128 v[84:87], v54 offset:4096
    ds_read_b128 v[88:91], v55 offset:4096
    ds_read_b128 v[92:95], v56 offset:4096
    ds_read_b128 v[96:99], v53 offset:8192
    ds_read_b128 v[100:103], v54 offset:8192
    ds_read_b128 v[104:107], v55 offset:8192
    ds_read_b128 v[108:111], v56 offset:8192
    ds_read_b128 v[112:115], v53 offset:12288
    ds_read_b128 v[116:119], v54 offset:12288
    ds_read_b128 v[120:123], v55 offset:12288
    ds_read_b128 v[124:127], v56 offset:12288
L_wc_18:
    ds_read_b32 v10, v3 offset:512
    s_waitcnt lgkmcnt(0)
    v_readfirstlane_b32 s51, v10
    s_nop 0
    s_cmp_ge_u32 s51, 4
    s_cbranch_scc0 L_wc_18
    ds_read_b128 v[144:147], v52 offset:0
    ds_read_b128 v[148:151], v52 offset:64
    ds_read_b128 v[152:155], v52 offset:128
    ds_read_b128 v[156:159], v52 offset:192
    s_waitcnt lgkmcnt(3)
    v_mfma_f32_16x16x32_bf16 v[128:131], v[64:67], v[144:147], 0
    v_mfma_f32_16x16x32_bf16 v[132:135], v[80:83], v[144:147], 0
    v_mfma_f32_16x16x32_bf16 v[136:139], v[96:99], v[144:147], 0
    v_mfma_f32_16x16x32_bf16 v[140:143], v[112:115], v[144:147], 0
    s_waitcnt lgkmcnt(2)
    v_mfma_f32_16x16x32_bf16 v[128:131], v[68:71], v[148:151], v[128:131]
    v_mfma_f32_16x16x32_bf16 v[132:135], v[84:87], v[148:151], v[132:135]
    v_mfma_f32_16x16x32_bf16 v[136:139], v[100:103], v[148:151], v[136:139]
    v_mfma_f32_16x16x32_bf16 v[140:143], v[116:119], v[148:151], v[140:143]
    s_waitcnt lgkmcnt(1)
    v_mfma_f32_16x16x32_bf16 v[128:131], v[72:75], v[152:155], v[128:131]
    v_mfma_f32_16x16x32_bf16 v[132:135], v[88:91], v[152:155], v[132:135]
    v_mfma_f32_16x16x32_bf16 v[136:139], v[104:107], v[152:155], v[136:139]
    v_mfma_f32_16x16x32_bf16 v[140:143], v[120:123], v[152:155], v[140:143]
    s_waitcnt lgkmcnt(0)
    v_mfma_f32_16x16x32_bf16 v[128:131], v[76:79], v[156:159], v[128:131]
    v_mfma_f32_16x16x32_bf16 v[132:135], v[92:95], v[156:159], v[132:135]
    v_mfma_f32_16x16x32_bf16 v[136:139], v[108:111], v[156:159], v[136:139]
    v_mfma_f32_16x16x32_bf16 v[140:143], v[124:127], v[156:159], v[140:143]
    s_mov_b32 s47, 0x3e0293ee
    s_nop 3
    v_max3_f32 v16, v128, v129, v130
    v_max3_f32 v17, v131, v132, v133
    v_max3_f32 v18, v134, v135, v136
    v_max3_f32 v19, v137, v138, v139
    v_max3_f32 v16, v16, v140, v141
    v_max3_f32 v17, v17, v142, v143
    v_max3_f32 v16, v16, v18, v19
    v_max_f32 v16, v16, v17
    v_mov_b32 v17, v16
    s_nop 1
    v_permlane16_swap_b32 v16, v17
    v_max_f32 v16, v16, v17
    v_mov_b32 v17, v16
    s_nop 1
    v_permlane32_swap_b32 v16, v17
    v_max_f32 v16, v16, v17
    s_mov_b64 exec, 0xf
    ds_write_b32 v58, v16 offset:7424
    s_mov_b64 exec, -1
    s_waitcnt lgkmcnt(0)
    ds_add_u32 v3, v9 offset:768
L_wc_19:
    ds_read_b32 v10, v3 offset:768
    s_waitcnt lgkmcnt(0)
    v_readfirstlane_b32 s51, v10
    s_nop 0
    s_cmp_ge_u32 s51, 4
    s_cbranch_scc0 L_wc_19
    ds_read_b128 v[16:19], v57 offset:7424
    s_waitcnt lgkmcnt(0)
    v_max3_f32 v16, v16, v17, v18
    v_max_f32 v16, v16, v19
    v_mul_f32 v61, s47, v16
    v_fma_f32 v128, v128, s47, -v61
    v_fma_f32 v129, v129, s47, -v61
    v_fma_f32 v130, v130, s47, -v61
    v_fma_f32 v131, v131, s47, -v61
    v_fma_f32 v132, v132, s47, -v61
    v_fma_f32 v133, v133, s47, -v61
    v_fma_f32 v134, v134, s47, -v61
    v_fma_f32 v135, v135, s47, -v61
    v_fma_f32 v136, v136, s47, -v61
    v_fma_f32 v137, v137, s47, -v61
    v_fma_f32 v138, v138, s47, -v61
    v_fma_f32 v139, v139, s47, -v61
    v_fma_f32 v140, v140, s47, -v61
    v_fma_f32 v141, v141, s47, -v61
    v_fma_f32 v142, v142, s47, -v61
    v_fma_f32 v143, v143, s47, -v61
    v_exp_f32 v128, v128
    v_exp_f32 v129, v129
    v_exp_f32 v130, v130
    v_exp_f32 v131, v131
    v_exp_f32 v132, v132
    v_exp_f32 v133, v133
    v_exp_f32 v134, v134
    v_exp_f32 v135, v135
    v_exp_f32 v136, v136
    v_exp_f32 v137, v137
    v_exp_f32 v138, v138
    v_exp_f32 v139, v139
    v_exp_f32 v140, v140
    v_exp_f32 v141, v141
    v_exp_f32 v142, v142
    v_exp_f32 v143, v143
    v_cvt_pk_bf16_f32 v44, v128, v129
    v_cvt_pk_bf16_f32 v45, v130, v131
    v_cvt_pk_bf16_f32 v46, v132, v133
    v_cvt_pk_bf16_f32 v47, v134, v135
    v_cvt_pk_bf16_f32 v48, v136, v137
    v_cvt_pk_bf16_f32 v49, v138, v139
    v_cvt_pk_bf16_f32 v50, v140, v141
    v_cvt_pk_bf16_f32 v51, v142, v143
    s_mov_b32 exec_lo, 0x000f000f
    s_mov_b32 exec_hi, 0x000f000f
    ds_write_b128 v60, v[44:47] offset:2048
    ds_write_b128 v60, v[48:51] offset:2304
    s_mov_b64 exec, -1
    v_add_f32 v128, v128, v136
    v_add_f32 v129, v129, v137
    v_add_f32 v130, v130, v138
    v_add_f32 v131, v131, v139
    v_add_f32 v132, v132, v140
    v_add_f32 v133, v133, v141
    v_add_f32 v134, v134, v142
    v_add_f32 v135, v135, v143
    v_add_f32 v128, v128, v132
    v_add_f32 v129, v129, v133
    v_add_f32 v130, v130, v134
    v_add_f32 v131, v131, v135
    v_add_f32 v128, v128, v130
    v_add_f32 v129, v129, v131
    v_add_f32 v16, v128, v129
    v_mov_b32 v17, v16
    s_nop 1
    v_permlane16_swap_b32 v16, v17
    v_add_f32 v16, v16, v17
    v_mov_b32 v17, v16
    s_nop 1
    v_permlane32_swap_b32 v16, v17
    v_add_f32 v16, v16, v17
    s_mov_b64 exec, 0xf
    ds_write_b32 v58, v16 offset:7488
    s_mov_b64 exec, -1
    s_waitcnt lgkmcnt(0)
    ds_add_u32 v3, v9 offset:1024
L_wc_20:
    ds_read_b32 v10, v3 offset:1024
    s_waitcnt lgkmcnt(0)
    v_readfirstlane_b32 s51, v10
    s_nop 0
    s_cmp_ge_u32 s51, 4
    s_cbranch_scc0 L_wc_20
    ds_read_b128 v[16:19], v57 offset:7488
    ds_read_b32 v10, v3 offset:0
    ds_read_b128 v[128:131], v59 offset:2048
    ds_read_b128 v[132:135], v59 offset:2304
    ds_read_b128 v[136:139], v59 offset:2560
    ds_read_b128 v[140:143], v59 offset:2816
    ds_read_b128 v[144:147], v59 offset:3072
    ds_read_b128 v[148:151], v59 offset:3328
    ds_read_b128 v[152:155], v59 offset:3584
    ds_read_b128 v[156:159], v59 offset:3840
    s_waitcnt lgkmcnt(8)
    v_readfirstlane_b32 s50, v10
    v_add_f32 v16, v16, v17
    v_add_f32 v18, v18, v19
    v_add_f32 v16, v16, v18
    v_rcp_f32 v62, v16
    v_log_f32 v16, v16
    v_mov_b32 v21, 0
    v_add_f32 v20, v16, v61
    s_lshl_b64 exec, 1, s3
    s_cmp_eq_u32 s53, 0
    s_cbranch_scc0 L_ls_21
    buffer_store_dwordx4 v[20:23], v15, s[40:43], s58 offen
L_le_22:
    s_mov_b64 exec, -1
    buffer_load_dwordx4 v[176:179], v28, s[40:43], s46 offen offset:0 sc1
    buffer_load_dwordx4 v[184:187], v1, s[40:43], s64 offen offset:0 sc1
    s_mov_b32 s69, 1
    s_waitcnt vmcnt(3)
    v_cmp_ne_u64 s[54:55], s[48:49], v[170:171]
    v_cmp_ne_u64 vcc, s[48:49], v[174:175]
    s_nop 0
    s_or_b64 s[54:55], s[54:55], vcc
    s_cmp_eq_u64 s[54:55], 0
    s_cbranch_scc0 L_fbad
    s_cmp_ge_i32 s50, 140
    s_cbranch_scc1 L_pv
    s_mov_b32 s69, 0
L_ffn1:
    v_and_b32 v19, 0xffff0000, v169
    v_lshlrev_b32 v18, 16, v169
    v_and_b32 v17, 0xffff0000, v168
    v_lshlrev_b32 v16, 16, v168
    v_and_b32 v39, 0xffff0000, v173
    v_lshlrev_b32 v38, 16, v173
    v_and_b32 v37, 0xffff0000, v172
    v_lshlrev_b32 v36, 16, v172
    v_mov_b32 v40, v16
    v_mov_b32 v41, v17
    v_mov_b32 v42, v18
    v_mov_b32 v43, v19
    v_permlane32_swap_b32 v16, v40
    v_permlane32_swap_b32 v17, v41
    v_permlane32_swap_b32 v18, v42
    v_permlane32_swap_b32 v19, v43
    v_add_f32 v16, v16, v40
    v_add_f32 v17, v17, v41
    v_add_f32 v18, v18, v42
    v_add_f32 v19, v19, v43
    v_mov_b32 v40, v36
    v_mov_b32 v41, v37
    v_mov_b32 v42, v38
    v_mov_b32 v43, v39
    v_permlane32_swap_b32 v36, v40
    v_permlane32_swap_b32 v37, v41
    v_permlane32_swap_b32 v38, v42
    v_permlane32_swap_b32 v39, v43
    v_add_f32 v36, v36, v40
    v_add_f32 v37, v37, v41
    v_add_f32 v38, v38, v42
    v_add_f32 v39, v39, v43
    v_cvt_pk_bf16_f32 v40, v16, v17
    v_cvt_pk_bf16_f32 v41, v18, v19
    v_cvt_pk_bf16_f32 v42, v36, v37
    v_cvt_pk_bf16_f32 v43, v38, v39
    v_and_b32 v19, 0xffff0000, v41
    v_lshlrev_b32 v18, 16, v41
    v_and_b32 v17, 0xffff0000, v40
    v_lshlrev_b32 v16, 16, v40
    v_and_b32 v39, 0xffff0000, v43
    v_lshlrev_b32 v38, 16, v43
    v_and_b32 v37, 0xffff0000, v42
    v_lshlrev_b32 v36, 16, v42
    v_mul_f32 v40, 0xbfb8aa3b, v16
    v_mul_f32 v41, 0xbfb8aa3b, v17
    v_mul_f32 v42, 0xbfb8aa3b, v18
    v_mul_f32 v43, 0xbfb8aa3b, v19
    v_exp_f32 v40, v40
    v_exp_f32 v41, v41
    v_exp_f32 v42, v42
    v_exp_f32 v43, v43
    v_add_f32 v40, 1.0, v40
    v_add_f32 v41, 1.0, v41
    v_add_f32 v42, 1.0, v42
    v_add_f32 v43, 1.0, v43
    v_rcp_f32 v40, v40
    v_rcp_f32 v41, v41
    v_rcp_f32 v42, v42
    v_rcp_f32 v43, v43
    v_mul_f32 v16, v16, v40
    v_mul_f32 v17, v17, v41
    v_mul_f32 v18, v18, v42
    v_mul_f32 v19, v19, v43
    v_mul_f32 v16, v16, v36
    v_mul_f32 v17, v17, v37
    v_mul_f32 v18, v18, v38
    v_mul_f32 v19, v19, v39
    v_cvt_pk_bf16_f32 v16, v16, v17
    v_cvt_pk_bf16_f32 v17, v18, v19
    v_cndmask_b32 v16, 0, v16, s[6:7]
    v_cndmask_b32 v17, 0, v17, s[6:7]
    s_mov_b32 exec_hi, 0
    ds_write_b64 v30, v[16:17]
    s_mov_b32 exec_hi, -1
    s_cmp_lg_u32 s69, 0
    s_cbranch_scc1 L_ffn_done
L_pv:
    s_cmp_ge_i32 s50, 132
    s_cbranch_scc1 L_wd_27
L_wp_26:
    ds_read_b32 v10, v3 offset:0
    s_waitcnt lgkmcnt(0)
    v_readfirstlane_b32 s50, v10
    s_nop 0
    s_cmp_ge_i32 s50, 132
    s_cbranch_scc0 L_wp_26
L_wd_27:
    ds_read_b64_tr_b16 v[64:65], v24 offset:0
    ds_read_b64_tr_b16 v[66:67], v24 offset:4096
    ds_read_b64_tr_b16 v[68:69], v25 offset:0
    ds_read_b64_tr_b16 v[70:71], v25 offset:4096
    ds_read_b64_tr_b16 v[72:73], v24 offset:8192
    ds_read_b64_tr_b16 v[74:75], v24 offset:12288
    ds_read_b64_tr_b16 v[76:77], v25 offset:8192
    ds_read_b64_tr_b16 v[78:79], v25 offset:12288
    ds_read_b64_tr_b16 v[80:81], v24 offset:16384
    ds_read_b64_tr_b16 v[82:83], v24 offset:20480
    ds_read_b64_tr_b16 v[84:85], v25 offset:16384
    ds_read_b64_tr_b16 v[86:87], v25 offset:20480
    ds_read_b64_tr_b16 v[88:89], v24 offset:24576
    ds_read_b64_tr_b16 v[90:91], v24 offset:28672
    ds_read_b64_tr_b16 v[92:93], v25 offset:24576
    ds_read_b64_tr_b16 v[94:95], v25 offset:28672
    s_cmp_ge_i32 s50, 148
    s_cbranch_scc1 L_wd_29
L_wp_28:
    ds_read_b32 v10, v3 offset:0
    s_waitcnt lgkmcnt(0)
    v_readfirstlane_b32 s50, v10
    s_nop 0
    s_cmp_ge_i32 s50, 148
    s_cbranch_scc0 L_wp_28
L_wd_29:
    ds_read_b64_tr_b16 v[96:97], v24 offset:32768
    ds_read_b64_tr_b16 v[98:99], v24 offset:36864
    ds_read_b64_tr_b16 v[100:101], v25 offset:32768
    ds_read_b64_tr_b16 v[102:103], v25 offset:36864
    ds_read_b64_tr_b16 v[104:105], v24 offset:40960
    ds_read_b64_tr_b16 v[106:107], v24 offset:45056
    ds_read_b64_tr_b16 v[108:109], v25 offset:40960
    ds_read_b64_tr_b16 v[110:111], v25 offset:45056
    s_waitcnt lgkmcnt(15)
    v_mfma_f32_16x16x32_bf16 v[32:35], v[64:67], v[128:131], 0
    s_waitcnt lgkmcnt(15)
    v_mfma_f32_16x16x32_bf16 v[36:39], v[68:71], v[128:131], 0
    s_waitcnt lgkmcnt(15)
    v_mfma_f32_16x16x32_bf16 v[32:35], v[72:75], v[132:135], v[32:35]
    s_waitcnt lgkmcnt(15)
    v_mfma_f32_16x16x32_bf16 v[36:39], v[76:79], v[132:135], v[36:39]
    s_waitcnt lgkmcnt(14)
    v_mfma_f32_16x16x32_bf16 v[32:35], v[80:83], v[136:139], v[32:35]
    s_waitcnt lgkmcnt(12)
    v_mfma_f32_16x16x32_bf16 v[36:39], v[84:87], v[136:139], v[36:39]
    s_waitcnt lgkmcnt(10)
    v_mfma_f32_16x16x32_bf16 v[32:35], v[88:91], v[140:143], v[32:35]
    s_waitcnt lgkmcnt(8)
    v_mfma_f32_16x16x32_bf16 v[36:39], v[92:95], v[140:143], v[36:39]
    s_cmp_ge_i32 s50, 156
    s_cbranch_scc1 L_wd_31
L_wp_30:
    ds_read_b32 v10, v3 offset:0
    s_waitcnt lgkmcnt(0)
    v_readfirstlane_b32 s50, v10
    s_nop 0
    s_cmp_ge_i32 s50, 156
    s_cbranch_scc0 L_wp_30
L_wd_31:
    ds_read_b64_tr_b16 v[112:113], v24 offset:49152
    ds_read_b64_tr_b16 v[114:115], v24 offset:53248
    ds_read_b64_tr_b16 v[116:117], v25 offset:49152
    ds_read_b64_tr_b16 v[118:119], v25 offset:53248
    s_waitcnt lgkmcnt(10)
    v_mfma_f32_16x16x32_bf16 v[32:35], v[96:99], v[144:147], v[32:35]
    s_waitcnt lgkmcnt(8)
    v_mfma_f32_16x16x32_bf16 v[36:39], v[100:103], v[144:147], v[36:39]
    s_waitcnt lgkmcnt(6)
    v_mfma_f32_16x16x32_bf16 v[32:35], v[104:107], v[148:151], v[32:35]
    s_waitcnt lgkmcnt(4)
    v_mfma_f32_16x16x32_bf16 v[36:39], v[108:111], v[148:151], v[36:39]
    s_waitcnt lgkmcnt(2)
    v_mfma_f32_16x16x32_bf16 v[32:35], v[112:115], v[152:155], v[32:35]
    s_waitcnt lgkmcnt(0)
    v_mfma_f32_16x16x32_bf16 v[36:39], v[116:119], v[152:155], v[36:39]
    s_barrier
    ds_read_b64_tr_b16 v[120:121], v24 offset:57344
    ds_read_b64_tr_b16 v[122:123], v24 offset:61440
    ds_read_b64_tr_b16 v[124:125], v25 offset:57344
    ds_read_b64_tr_b16 v[126:127], v25 offset:61440
    s_waitcnt lgkmcnt(2)
    v_mfma_f32_16x16x32_bf16 v[32:35], v[120:123], v[156:159], v[32:35]
    s_waitcnt lgkmcnt(0)
    v_mfma_f32_16x16x32_bf16 v[36:39], v[124:127], v[156:159], v[36:39]
    s_mov_b32 exec_lo, 0x00ff00ff
    s_mov_b32 exec_hi, 0x00ff00ff
    s_nop 5
    v_cndmask_b32 v16, v36, v32, s[4:5]
    v_cndmask_b32 v17, v37, v33, s[4:5]
    v_cndmask_b32 v18, v38, v34, s[4:5]
    v_cndmask_b32 v19, v39, v35, s[4:5]
    v_pk_mul_f32 v[16:17], v[16:17], v[62:63] op_sel_hi:[1,0]
    v_pk_mul_f32 v[18:19], v[18:19], v[62:63] op_sel_hi:[1,0]
    v_cvt_pk_bf16_f32 v20, v16, v17
    v_cvt_pk_bf16_f32 v21, v18, v19
    s_cmp_eq_u32 s53, 0
    s_cbranch_scc0 L_ls_32
    buffer_store_dwordx4 v[20:23], v14, s[40:43], s57 offen
L_le_33:
    s_mov_b64 exec, -1
    s_cmp_lg_u32 s69, 0
    s_cbranch_scc1 L_ffn
L_ffn_done:
    s_waitcnt vmcnt(1)
    v_cmp_ne_u64 s[54:55], s[48:49], v[178:179]
    v_cmp_ne_u64 vcc, s[48:49], v[186:187]
    s_nop 0
    s_or_b64 s[54:55], s[54:55], vcc
    s_cmp_eq_u64 s[54:55], 0
    s_cbranch_scc0 L_gbad
L_gok:
    v_add_f32_dpp v195, v176, v176 row_ror:8 row_mask:0xf bank_mask:0xf
    v_mul_f32 v195, 0xbfb8aa3b, v195
    v_exp_f32 v195, v195
    s_nop 0
    v_add_f32 v195, 1.0, v195
    v_rcp_f32 v195, v195
    s_nop 0
    v_sub_f32 v196, 1.0, v195
    v_mov_b32 v152, 0
    v_mov_b32 v153, 0
    v_mov_b32 v154, 0
    v_mov_b32 v155, 0
    buffer_load_dwordx4 v[48:51], v189, s[40:43], s66 offen offset:0 sc1
    s_mov_b32 s18, 0
    s_mov_b32 s52, 0
    s_waitcnt lgkmcnt(0)
    s_barrier
    buffer_load_dwordx4 v[32:35], v188, s[40:43], s59 offen offset:0 sc1
    buffer_load_dwordx4 v[36:39], v188, s[40:43], s59 offen offset:512 sc1
    buffer_load_dwordx4 v[40:43], v188, s[40:43], s59 offen offset:1024 sc1
    buffer_load_dwordx4 v[44:47], v188, s[40:43], s59 offen offset:1536 sc1
    s_waitcnt vmcnt(4)
    v_cmp_ne_u64 vcc, s[48:49], v[50:51]
    s_nop 0
    s_cbranch_vccnz L_wbad
L_wok:
    ds_read_b128 v[160:163], v192
    ds_read_b128 v[164:167], v192 offset:64
    ds_read_b64_tr_b16 v[80:81], v12 offset:16384
    ds_read_b64_tr_b16 v[82:83], v12 offset:16896
    ds_read_b64_tr_b16 v[84:85], v12 offset:20480
    ds_read_b64_tr_b16 v[86:87], v12 offset:20992
    ds_read_b64_tr_b16 v[64:65], v12 offset:0
    ds_read_b64_tr_b16 v[66:67], v12 offset:512
    ds_read_b64_tr_b16 v[68:69], v12 offset:4096
    ds_read_b64_tr_b16 v[70:71], v12 offset:4608
    ds_read_b64_tr_b16 v[72:73], v12 offset:8192
    ds_read_b64_tr_b16 v[74:75], v12 offset:8704
    ds_read_b64_tr_b16 v[76:77], v12 offset:12288
    ds_read_b64_tr_b16 v[78:79], v12 offset:12800
    v_mov_b32_dpp v144, v48 quad_perm:[0,0,0,0] row_mask:0xf bank_mask:0xf
    v_mov_b32_dpp v145, v48 quad_perm:[1,1,1,1] row_mask:0xf bank_mask:0xf
    v_mov_b32_dpp v146, v48 quad_perm:[2,2,2,2] row_mask:0xf bank_mask:0xf
    v_mov_b32_dpp v147, v48 quad_perm:[3,3,3,3] row_mask:0xf bank_mask:0xf
    v_max3_f32 v16, v144, v145, v146
    v_max_f32 v16, v16, v147
    v_sub_f32 v144, v144, v16
    v_sub_f32 v145, v145, v16
    v_sub_f32 v146, v146, v16
    v_sub_f32 v147, v147, v16
    v_exp_f32 v144, v144
    v_exp_f32 v145, v145
    v_exp_f32 v146, v146
    v_exp_f32 v147, v147
    v_add_f32 v16, v144, v145
    v_add_f32 v17, v146, v147
    v_add_f32 v16, v16, v17
    v_rcp_f32 v16, v16
    s_nop 0
    v_mul_f32 v144, v144, v16
    v_mul_f32 v145, v145, v16
    v_mul_f32 v146, v146, v16
    v_mul_f32 v147, v147, v16
    s_waitcnt vmcnt(3)
    v_cmp_ne_u64 vcc, s[48:49], v[34:35]
    v_and_b32 v19, 0xffff0000, v33
    v_lshlrev_b32 v18, 16, v33
    v_and_b32 v17, 0xffff0000, v32
    v_lshlrev_b32 v16, 16, v32
    s_cbranch_vccnz L_om0
    v_pk_fma_f32 v[152:153], v[16:17], v[144:145], v[152:153] op_sel_hi:[1,0,1]
    v_pk_fma_f32 v[154:155], v[18:19], v[144:145], v[154:155] op_sel_hi:[1,0,1]
L_on0:
    s_waitcnt vmcnt(2)
    v_cmp_ne_u64 vcc, s[48:49], v[38:39]
    v_and_b32 v19, 0xffff0000, v37
    v_lshlrev_b32 v18, 16, v37
    v_and_b32 v17, 0xffff0000, v36
    v_lshlrev_b32 v16, 16, v36
    s_cbranch_vccnz L_om1
    v_pk_fma_f32 v[152:153], v[16:17], v[144:145], v[152:153] op_sel:[0,1,0] op_sel_hi:[1,1,1]
    v_pk_fma_f32 v[154:155], v[18:19], v[144:145], v[154:155] op_sel:[0,1,0] op_sel_hi:[1,1,1]
L_on1:
    s_waitcnt vmcnt(1)
    v_cmp_ne_u64 vcc, s[48:49], v[42:43]
    v_and_b32 v19, 0xffff0000, v41
    v_lshlrev_b32 v18, 16, v41
    v_and_b32 v17, 0xffff0000, v40
    v_lshlrev_b32 v16, 16, v40
    s_cbranch_vccnz L_om2
    v_pk_fma_f32 v[152:153], v[16:17], v[146:147], v[152:153] op_sel_hi:[1,0,1]
    v_pk_fma_f32 v[154:155], v[18:19], v[146:147], v[154:155] op_sel_hi:[1,0,1]
L_on2:
    s_waitcnt vmcnt(0)
    v_cmp_ne_u64 vcc, s[48:49], v[46:47]
    v_and_b32 v19, 0xffff0000, v45
    v_lshlrev_b32 v18, 16, v45
    v_and_b32 v17, 0xffff0000, v44
    v_lshlrev_b32 v16, 16, v44
    s_cbranch_vccnz L_om3
    v_pk_fma_f32 v[152:153], v[16:17], v[146:147], v[152:153] op_sel:[0,1,0] op_sel_hi:[1,1,1]
    v_pk_fma_f32 v[154:155], v[18:19], v[146:147], v[154:155] op_sel:[0,1,0] op_sel_hi:[1,1,1]
L_on3:
    s_cmp_eq_u32 s18, 0
    s_cbranch_scc0 L_opoll
L_ogot:
    v_cvt_pk_bf16_f32 v48, v152, v153
    v_cvt_pk_bf16_f32 v49, v154, v155
    ds_write_b64 v190, v[48:49]
    s_waitcnt lgkmcnt(0)
    s_barrier
    ds_read_b128 v[32:35], v191 offset:0
    ds_read_b128 v[36:39], v191 offset:64
    ds_read_b128 v[40:43], v191 offset:128
    ds_read_b128 v[44:47], v191 offset:192
    v_mfma_f32_16x16x32_bf16 v[148:151], v[80:83], v[160:163], 0
    v_mfma_f32_16x16x32_bf16 v[148:151], v[84:87], v[164:167], v[148:151]
    s_waitcnt lgkmcnt(3)
    v_mfma_f32_16x16x32_bf16 v[48:51], v[64:67], v[32:35], 0
    s_waitcnt lgkmcnt(2)
    v_mfma_f32_16x16x32_bf16 v[48:51], v[68:71], v[36:39], v[48:51]
    s_waitcnt lgkmcnt(1)
    v_mfma_f32_16x16x32_bf16 v[48:51], v[72:75], v[40:43], v[48:51]
    s_waitcnt lgkmcnt(0)
    v_mfma_f32_16x16x32_bf16 v[48:51], v[76:79], v[44:47], v[48:51]
    v_cndmask_b32 v148, v150, v148, s[62:63]
    v_cndmask_b32 v149, v151, v149, s[62:63]
    v_pk_mul_f32 v[148:149], v[148:149], v[196:197] op_sel_hi:[1,0]
    s_mov_b32 s56, s28
    s_mov_b32 s57, s29
    s_mov_b32 s58, 8192
    s_mov_b32 s59, 0x20000
    s_nop 0
    v_cndmask_b32 v48, v50, v48, s[62:63]
    v_cndmask_b32 v49, v51, v49, s[62:63]
    v_fma_f32 v48, v195, v48, v148
    v_fma_f32 v49, v195, v49, v149
    v_cndmask_b32 v32, v48, 1.0, s[8:9]
    buffer_atomic_add_f32 v32, v193, s[40:43], s60 offen sc0
    v_cndmask_b32 v33, v49, 1.0, s[8:9]
    buffer_atomic_add_f32 v33, v193, s[40:43], s60 offen offset:256 sc0
    v_mov_b32_dpp v36, v48 quad_perm:[3,3,3,3] row_mask:0xf bank_mask:0xf
    v_mov_b32_dpp v37, v49 quad_perm:[3,3,3,3] row_mask:0xf bank_mask:0xf
    v_cndmask_b32 v50, v36, v37, s[10:11]
    v_cndmask_b32 v34, v50, 1.0, s[12:13]
    s_mov_b32 exec_lo, 0x70707070
    s_mov_b32 exec_hi, 0x70707070
    buffer_atomic_add_f32 v34, v193, s[40:43], s60 offen offset:512 sc0
    s_mov_b64 exec, -1
    s_mov_b32 s47, 0x41f80000
    s_lshr_b64 s[10:11], s[8:9], 1
    s_waitcnt vmcnt(2)
    v_cmp_eq_f32 vcc, s47, v32
    v_add_f32 v37, v32, v48
    v_cvt_pk_bf16_f32 v40, v37, v37
    s_and_b64 s[14:15], vcc, s[8:9]
    s_lshr_b64 s[4:5], s[14:15], 7
    s_sub_u32 s14, s14, s4
    s_sub_u32 s15, s15, s5
    s_waitcnt vmcnt(1)
    v_cmp_eq_f32 vcc, s47, v33
    v_add_f32 v37, v33, v49
    v_cvt_pk_bf16_f32 v41, v37, v37
    s_and_b64 s[16:17], vcc, s[8:9]
    s_lshr_b64 s[4:5], s[16:17], 7
    s_sub_u32 s16, s16, s4
    s_sub_u32 s17, s17, s5
    s_waitcnt vmcnt(0)
    v_cmp_eq_f32 vcc, s47, v34
    v_add_f32 v37, v34, v50
    v_cvt_pk_bf16_f32 v42, v37, v37
    s_and_b64 s[18:19], vcc, s[10:11]
    s_lshr_b64 s[4:5], s[18:19], 2
    s_sub_u32 s18, s18, s4
    s_sub_u32 s19, s19, s5
    s_mov_b64 exec, s[14:15]
    s_cbranch_execz L_fs_56
    buffer_store_short v40, v194, s[56:59], s67 offen offset:0
L_fs_56:
    s_mov_b64 exec, s[16:17]
    s_cbranch_execz L_fs_57
    buffer_store_short v41, v194, s[56:59], s67 offen offset:2
L_fs_57:
    s_mov_b64 exec, s[18:19]
    s_cbranch_execz L_fs_58
    buffer_store_short v42, v208, s[56:59], s67 offen offset:0
L_fs_58:
    s_or_b32 s47, s32, s3
    s_cbranch_scc1 L_cend
    s_bitcmp1_b32 s14, 0
    s_cbranch_scc0 L_cend
    s_mov_b64 exec, 1
    buffer_store_dwordx2 v[22:23], v2, s[40:43], 0 offen sc1
L_cend:
L_end:
    s_endpgm
L_ls_7:
    buffer_store_dwordx4 v[20:23], v13, s[40:43], s36 offen sc1
    s_branch L_le_8
L_ls_21:
    buffer_store_dwordx4 v[20:23], v15, s[40:43], s58 offen sc1
    s_branch L_le_22
L_fbad:
    buffer_load_dwordx4 v[168:171], v27, s[40:43], s37 offen offset:0 sc1
    buffer_load_dwordx4 v[172:175], v27, s[40:43], s44 offen offset:0 sc1
    s_branch L_pv
L_ffn:
    s_mov_b32 s52, 0
    s_waitcnt vmcnt(1)
    s_branch L_pc_24
L_pl_23:
    buffer_load_dwordx4 v[168:171], v27, s[40:43], s37 offen offset:0 sc1
    buffer_load_dwordx4 v[172:175], v27, s[40:43], s44 offen offset:0 sc1
    s_waitcnt vmcnt(0)
L_pc_24:
    v_cmp_ne_u64 s[54:55], s[48:49], v[170:171]
    v_cmp_ne_u64 vcc, s[48:49], v[174:175]
    s_nop 0
    s_or_b64 s[54:55], s[54:55], vcc
    s_cmp_eq_u64 s[54:55], 0
    s_cbranch_scc1 L_pd_25
    s_add_u32 s52, s52, 1
    s_cmp_lt_u32 s52, 400000
    s_cbranch_scc1 L_pl_23
L_pd_25:
    s_branch L_ffn1
L_ls_32:
    buffer_store_dwordx4 v[20:23], v14, s[40:43], s57 offen sc1
    s_branch L_le_33
L_gbad:
    s_mov_b32 s52, 0
L_pl_34:
    buffer_load_dwordx4 v[176:179], v28, s[40:43], s46 offen offset:0 sc1
    buffer_load_dwordx4 v[184:187], v1, s[40:43], s64 offen offset:0 sc1
    s_waitcnt vmcnt(0)
L_pc_35:
    v_cmp_ne_u64 s[54:55], s[48:49], v[178:179]
    v_cmp_ne_u64 vcc, s[48:49], v[186:187]
    s_nop 0
    s_or_b64 s[54:55], s[54:55], vcc
    s_cmp_eq_u64 s[54:55], 0
    s_cbranch_scc1 L_pd_36
    s_add_u32 s52, s52, 1
    s_cmp_lt_u32 s52, 400000
    s_cbranch_scc1 L_pl_34
L_pd_36:
    s_branch L_gok
L_wbad:
    s_mov_b32 s52, 0
L_pl_37:
    buffer_load_dwordx4 v[48:51], v189, s[40:43], s66 offen offset:0 sc1
    s_waitcnt vmcnt(0)
L_pc_38:
    v_cmp_ne_u64 s[54:55], s[48:49], v[50:51]
    s_nop 0
    s_cmp_eq_u64 s[54:55], 0
    s_cbranch_scc1 L_pd_39
    s_add_u32 s52, s52, 1
    s_cmp_lt_u32 s52, 400000
    s_cbranch_scc1 L_pl_37
L_pd_39:
    s_branch L_wok
L_om0:
    s_bitset1_b32 s18, 0
    s_branch L_on0
L_om1:
    s_bitset1_b32 s18, 1
    s_branch L_on1
L_om2:
    s_bitset1_b32 s18, 2
    s_branch L_on2
L_om3:
    s_bitset1_b32 s18, 3
    s_branch L_on3
L_opoll:
    s_bitcmp1_b32 s18, 0
    s_cbranch_scc0 L_o2_40
    buffer_load_dwordx4 v[32:35], v188, s[40:43], s59 offen offset:0 sc1
L_o2_40:
    s_bitcmp1_b32 s18, 1
    s_cbranch_scc0 L_o2_41
    buffer_load_dwordx4 v[36:39], v188, s[40:43], s59 offen offset:512 sc1
L_o2_41:
    s_bitcmp1_b32 s18, 2
    s_cbranch_scc0 L_o2_42
    buffer_load_dwordx4 v[40:43], v188, s[40:43], s59 offen offset:1024 sc1
L_o2_42:
    s_bitcmp1_b32 s18, 3
    s_cbranch_scc0 L_o2_43
    buffer_load_dwordx4 v[44:47], v188, s[40:43], s59 offen offset:1536 sc1
L_o2_43:
    s_bitcmp1_b32 s18, 0
    s_cbranch_scc0 L_o3_44
L_o4_45:
    s_waitcnt vmcnt(0)
    v_cmp_ne_u64 vcc, s[48:49], v[34:35]
    s_nop 0
    s_cbranch_vccz L_o5_46
    buffer_load_dwordx4 v[32:35], v188, s[40:43], s59 offen offset:0 sc1
    s_add_u32 s52, s52, 1
    s_cmp_lt_u32 s52, 400000
    s_cbranch_scc1 L_o4_45
    s_waitcnt vmcnt(0)
L_o5_46:
    v_and_b32 v19, 0xffff0000, v33
    v_lshlrev_b32 v18, 16, v33
    v_and_b32 v17, 0xffff0000, v32
    v_lshlrev_b32 v16, 16, v32
    v_pk_fma_f32 v[152:153], v[16:17], v[144:145], v[152:153] op_sel_hi:[1,0,1]
    v_pk_fma_f32 v[154:155], v[18:19], v[144:145], v[154:155] op_sel_hi:[1,0,1]
L_o3_44:
    s_bitcmp1_b32 s18, 1
    s_cbranch_scc0 L_o3_47
L_o4_48:
    s_waitcnt vmcnt(0)
    v_cmp_ne_u64 vcc, s[48:49], v[38:39]
    s_nop 0
    s_cbranch_vccz L_o5_49
    buffer_load_dwordx4 v[36:39], v188, s[40:43], s59 offen offset:512 sc1
    s_add_u32 s52, s52, 1
    s_cmp_lt_u32 s52, 400000
    s_cbranch_scc1 L_o4_48
    s_waitcnt vmcnt(0)
L_o5_49:
    v_and_b32 v19, 0xffff0000, v37
    v_lshlrev_b32 v18, 16, v37
    v_and_b32 v17, 0xffff0000, v36
    v_lshlrev_b32 v16, 16, v36
    v_pk_fma_f32 v[152:153], v[16:17], v[144:145], v[152:153] op_sel:[0,1,0] op_sel_hi:[1,1,1]
    v_pk_fma_f32 v[154:155], v[18:19], v[144:145], v[154:155] op_sel:[0,1,0] op_sel_hi:[1,1,1]
L_o3_47:
    s_bitcmp1_b32 s18, 2
    s_cbranch_scc0 L_o3_50
L_o4_51:
    s_waitcnt vmcnt(0)
    v_cmp_ne_u64 vcc, s[48:49], v[42:43]
    s_nop 0
    s_cbranch_vccz L_o5_52
    buffer_load_dwordx4 v[40:43], v188, s[40:43], s59 offen offset:1024 sc1
    s_add_u32 s52, s52, 1
    s_cmp_lt_u32 s52, 400000
    s_cbranch_scc1 L_o4_51
    s_waitcnt vmcnt(0)
L_o5_52:
    v_and_b32 v19, 0xffff0000, v41
    v_lshlrev_b32 v18, 16, v41
    v_and_b32 v17, 0xffff0000, v40
    v_lshlrev_b32 v16, 16, v40
    v_pk_fma_f32 v[152:153], v[16:17], v[146:147], v[152:153] op_sel_hi:[1,0,1]
    v_pk_fma_f32 v[154:155], v[18:19], v[146:147], v[154:155] op_sel_hi:[1,0,1]
L_o3_50:
    s_bitcmp1_b32 s18, 3
    s_cbranch_scc0 L_o3_53
L_o4_54:
    s_waitcnt vmcnt(0)
    v_cmp_ne_u64 vcc, s[48:49], v[46:47]
    s_nop 0
    s_cbranch_vccz L_o5_55
    buffer_load_dwordx4 v[44:47], v188, s[40:43], s59 offen offset:1536 sc1
    s_add_u32 s52, s52, 1
    s_cmp_lt_u32 s52, 400000
    s_cbranch_scc1 L_o4_54
    s_waitcnt vmcnt(0)
L_o5_55:
    v_and_b32 v19, 0xffff0000, v45
    v_lshlrev_b32 v18, 16, v45
    v_and_b32 v17, 0xffff0000, v44
    v_lshlrev_b32 v16, 16, v44
    v_pk_fma_f32 v[152:153], v[16:17], v[146:147], v[152:153] op_sel:[0,1,0] op_sel_hi:[1,1,1]
    v_pk_fma_f32 v[154:155], v[18:19], v[146:147], v[154:155] op_sel:[0,1,0] op_sel_hi:[1,1,1]
L_o3_53:
    s_branch L_ogot
L_loader3:
    s_mov_b32 s44, s8
    s_mov_b32 s45, s9
    s_mov_b32 s46, 67108864
    s_mov_b32 s47, 0x20000
    v_add_u32 v15, 0, v12
    v_lshlrev_b32 v15, 1, v15
    v_xor_b32 v15, v15, v13
    v_lshl_add_u32 v8, v15, 4, v14
    v_add_u32 v15, 4, v12
    v_lshlrev_b32 v15, 1, v15
    v_xor_b32 v15, v15, v13
    v_lshl_add_u32 v9, v15, 4, v14
    s_mov_b32 s37, 65536
L_ld_3:
    s_waitcnt vmcnt(24)
    ds_write_b32 v18, v19 offset:0
    s_mov_b32 m0, s37
    s_add_u32 s37, s37, 4096
    buffer_load_dwordx4 v8, s[44:47], s32 offen offset:0 nt lds
    buffer_load_dwordx4 v9, s[44:47], s32 offen offset:1024 nt lds
    buffer_load_dwordx4 v8, s[44:47], s32 offen offset:2048 nt lds
    buffer_load_dwordx4 v9, s[44:47], s32 offen offset:3072 nt lds
    v_add_u32 v19, 4, v19
    s_add_u32 s32, s32, 4096
    s_and_b32 s32, s32, 0xffff
    s_or_b32 s32, s32, s59
    s_cmp_lt_u32 s37, 98304
    s_cbranch_scc1 L_ld_3
L_ws_4:
    ds_read_b32 v20, v18 offset:256
    s_waitcnt lgkmcnt(0)
    v_readfirstlane_b32 s37, v20
    s_nop 0
    s_cmp_ge_u32 s37, 4
    s_cbranch_scc0 L_ws_4
    s_mov_b32 s40, s12
    s_mov_b32 s41, s13
    s_mov_b32 s42, 4194304
    s_mov_b32 s43, 0x20000
    s_bitcmp1_b32 s30, 0
    s_cselect_b32 s55, 48, 64
    s_mul_i32 s51, s55, s48
    s_lshl_b32 s53, s53, 6
    s_add_u32 s51, s51, s53
    s_add_u32 s55, s55, s51
    s_lshl_b32 s55, s55, 10
    s_mov_b32 s60, s20
    s_mov_b32 s61, s21
    s_mov_b32 s62, s55
    s_mov_b32 s63, 0x20000
    s_lshl_b32 s50, s30, 2
    s_add_u32 s50, s50, s48
    s_lshr_b32 s49, s31, 2
    s_lshl_b32 s49, s49, 7
    s_lshl_b32 s51, s51, 10
    s_add_u32 s51, s51, s49
    s_lshl_b32 s50, s50, 17
    s_add_u32 s50, s50, s49
    v_lshl_add_u32 v20, v16, 10, v17
    v_xor_b32 v21, 64, v20
    v_add_u32 v21, 7168, v21
    v_add_u32 v22, 14336, v20
    v_add_u32 v23, 14336, v21
    s_waitcnt vmcnt(24)
    ds_write_b32 v18, v19 offset:0
    s_mov_b32 m0, 98304
    v_add_u32 v19, 4, v19
    buffer_load_dwordx4 v8, s[44:47], s32 offen offset:0 nt lds
    buffer_load_dwordx4 v9, s[44:47], s32 offen offset:1024 nt lds
    buffer_load_dwordx4 v8, s[44:47], s32 offen offset:2048 nt lds
    buffer_load_dwordx4 v9, s[44:47], s32 offen offset:3072 nt lds
    s_add_u32 s32, s32, 4096
    s_and_b32 s32, s32, 0xffff
    s_or_b32 s32, s32, s59
    s_waitcnt vmcnt(24)
    ds_write_b32 v18, v19 offset:0
    s_mov_b32 m0, 102400
    v_add_u32 v19, 4, v19
    buffer_load_dwordx4 v8, s[44:47], s32 offen offset:0 nt lds
    buffer_load_dwordx4 v9, s[44:47], s32 offen offset:1024 nt lds
    buffer_load_dwordx4 v8, s[44:47], s32 offen offset:2048 nt lds
    buffer_load_dwordx4 v9, s[44:47], s32 offen offset:3072 nt lds
    s_add_u32 s32, s32, 4096
    s_and_b32 s32, s32, 0xffff
    s_or_b32 s32, s32, s59
    s_waitcnt vmcnt(24)
    ds_write_b32 v18, v19 offset:0
    s_mov_b32 m0, 106496
    v_add_u32 v19, 4, v19
    buffer_load_dwordx4 v8, s[44:47], s32 offen offset:0 nt lds
    buffer_load_dwordx4 v9, s[44:47], s32 offen offset:1024 nt lds
    buffer_load_dwordx4 v8, s[44:47], s32 offen offset:2048 nt lds
    buffer_load_dwordx4 v9, s[44:47], s32 offen offset:3072 nt lds
    s_add_u32 s32, s32, 4096
    s_and_b32 s32, s32, 0xffff
    s_or_b32 s32, s32, s59
    s_waitcnt vmcnt(24)
    ds_write_b32 v18, v19 offset:0
    s_mov_b32 m0, 110592
    v_add_u32 v19, 4, v19
    buffer_load_dwordx4 v8, s[44:47], s32 offen offset:0 nt lds
    buffer_load_dwordx4 v9, s[44:47], s32 offen offset:1024 nt lds
    buffer_load_dwordx4 v8, s[44:47], s32 offen offset:2048 nt lds
    buffer_load_dwordx4 v9, s[44:47], s32 offen offset:3072 nt lds
    s_add_u32 s32, s32, 4096
    s_and_b32 s32, s32, 0xffff
    s_or_b32 s32, s32, s59
    s_waitcnt vmcnt(24)
    ds_write_b32 v18, v19 offset:0
    s_mov_b32 m0, 114688
    v_add_u32 v19, 4, v19
    buffer_load_dwordx4 v8, s[44:47], s32 offen offset:0 nt lds
    buffer_load_dwordx4 v9, s[44:47], s32 offen offset:1024 nt lds
    buffer_load_dwordx4 v8, s[44:47], s32 offen offset:2048 nt lds
    buffer_load_dwordx4 v9, s[44:47], s32 offen offset:3072 nt lds
    s_add_u32 s32, s32, 4096
    s_and_b32 s32, s32, 0xffff
    s_or_b32 s32, s32, s59
    s_waitcnt vmcnt(24)
    ds_write_b32 v18, v19 offset:0
    s_mov_b32 m0, 118784
    v_add_u32 v19, 4, v19
    buffer_load_dwordx4 v8, s[44:47], s32 offen offset:0 nt lds
    buffer_load_dwordx4 v9, s[44:47], s32 offen offset:1024 nt lds
    buffer_load_dwordx4 v8, s[44:47], s32 offen offset:2048 nt lds
    buffer_load_dwordx4 v9, s[44:47], s32 offen offset:3072 nt lds
    s_add_u32 s32, s32, 4096
    s_and_b32 s32, s32, 0xffff
    s_or_b32 s32, s32, s59
    s_waitcnt vmcnt(24)
    ds_write_b32 v18, v19 offset:0
    s_mov_b32 m0, 122880
    v_add_u32 v19, 4, v19
    buffer_load_dwordx4 v8, s[44:47], s32 offen offset:0 nt lds
    buffer_load_dwordx4 v9, s[44:47], s32 offen offset:1024 nt lds
    buffer_load_dwordx4 v8, s[44:47], s32 offen offset:2048 nt lds
    buffer_load_dwordx4 v9, s[44:47], s32 offen offset:3072 nt lds
    s_add_u32 s32, s32, 4096
    s_and_b32 s32, s32, 0xffff
    s_or_b32 s32, s32, s59
    s_waitcnt vmcnt(24)
    ds_write_b32 v18, v19 offset:0
    s_mov_b32 m0, 126976
    v_add_u32 v19, 4, v19
    buffer_load_dwordx4 v8, s[44:47], s32 offen offset:0 nt lds
    buffer_load_dwordx4 v9, s[44:47], s32 offen offset:1024 nt lds
    buffer_load_dwordx4 v8, s[44:47], s32 offen offset:2048 nt lds
    buffer_load_dwordx4 v9, s[44:47], s32 offen offset:3072 nt lds
    s_add_u32 s32, s32, 4096
    s_and_b32 s32, s32, 0xffff
    s_or_b32 s32, s32, s59
    s_waitcnt vmcnt(24)
    ds_write_b32 v18, v19 offset:0
    s_mov_b32 m0, 131072
    v_add_u32 v19, 4, v19
    buffer_load_dwordx4 v20, s[40:43], s50 offen offset:0 nt lds
    buffer_load_dwordx4 v21, s[40:43], s50 offen offset:1024 nt lds
    buffer_load_dwordx4 v22, s[40:43], s50 offen offset:2048 nt lds
    buffer_load_dwordx4 v23, s[40:43], s50 offen offset:3072 nt lds
    s_add_u32 s50, s50, 32768
    s_waitcnt vmcnt(24)
    ds_write_b32 v18, v19 offset:0
    s_mov_b32 m0, 135168
    v_add_u32 v19, 4, v19
    buffer_load_dwordx4 v20, s[40:43], s50 offen offset:0 nt lds
    buffer_load_dwordx4 v21, s[40:43], s50 offen offset:1024 nt lds
    buffer_load_dwordx4 v22, s[40:43], s50 offen offset:2048 nt lds
    buffer_load_dwordx4 v23, s[40:43], s50 offen offset:3072 nt lds
    s_add_u32 s50, s50, 32768
    s_waitcnt vmcnt(24)
    ds_write_b32 v18, v19 offset:0
    s_mov_b32 m0, 139264
    v_add_u32 v19, 4, v19
    buffer_load_dwordx4 v20, s[40:43], s50 offen offset:0 nt lds
    buffer_load_dwordx4 v21, s[40:43], s50 offen offset:1024 nt lds
    buffer_load_dwordx4 v22, s[40:43], s50 offen offset:2048 nt lds
    buffer_load_dwordx4 v23, s[40:43], s50 offen offset:3072 nt lds
    s_add_u32 s50, s50, 32768
    s_waitcnt vmcnt(24)
    ds_write_b32 v18, v19 offset:0
    s_mov_b32 m0, 143360
    v_add_u32 v19, 4, v19
    buffer_load_dwordx4 v20, s[40:43], s50 offen offset:0 nt lds
    buffer_load_dwordx4 v21, s[40:43], s50 offen offset:1024 nt lds
    buffer_load_dwordx4 v22, s[40:43], s50 offen offset:2048 nt lds
    buffer_load_dwordx4 v23, s[40:43], s50 offen offset:3072 nt lds
    s_add_u32 s50, s50, 32768
    s_waitcnt vmcnt(24)
    ds_write_b32 v18, v19 offset:0
    s_mov_b32 m0, 147456
    v_add_u32 v19, 4, v19
    buffer_load_dwordx4 v20, s[60:63], s51 offen offset:0 nt lds
    buffer_load_dwordx4 v21, s[60:63], s51 offen offset:1024 nt lds
    buffer_load_dwordx4 v22, s[60:63], s51 offen offset:2048 nt lds
    buffer_load_dwordx4 v23, s[60:63], s51 offen offset:3072 nt lds
    s_add_u32 s51, s51, 32768
    s_waitcnt vmcnt(24)
    ds_write_b32 v18, v19 offset:0
    s_mov_b32 m0, 151552
    v_add_u32 v19, 4, v19
    buffer_load_dwordx4 v20, s[60:63], s51 offen offset:0 nt lds
    buffer_load_dwordx4 v21, s[60:63], s51 offen offset:1024 nt lds
    buffer_load_dwordx4 v22, s[60:63], s51 offen offset:2048 nt lds
    buffer_load_dwordx4 v23, s[60:63], s51 offen offset:3072 nt lds
    s_add_u32 s51, s51, 32768
    s_waitcnt vmcnt(24)
    s_barrier
    s_waitcnt vmcnt(0)
    s_barrier
    s_endpgm
L_notile:
    s_load_dwordx2 s[44:45], s[0:1], 72
    s_lshl_b32 s33, s2, 6
    s_and_b32 s33, s33, 512
    s_movk_i32 s46, 0x400
    v_lshlrev_b32 v8, 7, v16
    v_lshl_add_u32 v8, v13, 4, v8
    s_waitcnt lgkmcnt(0)
    s_bitcmp1_b32 s31, 1
    s_cbranch_scc1 L_tiledone
    buffer_load_dwordx4 v8, s[44:47], s33 offen lds
    s_branch L_tiledone
    .fill (10496 - (. - gated_mix__sliding_block_cached__glu_gated_swiglu__decode_kernel)) / 4, 4, 0xbf810000
.section .rodata,"a"
.p2align 6
.amdhsa_kernel gated_mix__sliding_block_cached__glu_gated_swiglu__decode_kernel
  .amdhsa_next_free_vgpr 256
  .amdhsa_next_free_sgpr 102
  .amdhsa_accum_offset 256
  .amdhsa_group_segment_fixed_size 0
  .amdhsa_kernarg_size 104
  .amdhsa_user_sgpr_count 2
  .amdhsa_user_sgpr_kernarg_segment_ptr 1
  .amdhsa_system_sgpr_workgroup_id_x 1
.end_amdhsa_kernel
```
